```python
import torch

def _softmax(x, axis=-1):
    return torch.softmax(x, dim=axis)
def _gelu(x):
    return torch.nn.functional.gelu(x, approximate="tanh")
def _silu(x):
    return torch.nn.functional.silu(x)
def _sigmoid(x):
    return torch.sigmoid(x)
def _layernorm(x, axis=-1, eps=1e-5):
    m = x.mean(dim=axis, keepdim=True)
    v = x.var(dim=axis, keepdim=True, unbiased=False)
    return (x - m) / torch.sqrt(v + eps)
def _scatter_add(tgt, idx, src, axis=0):
    return tgt.clone().index_add_(axis, idx, src)
def _segment_sum(src, seg, n):
    out = torch.zeros((n,) + src.shape[1:], dtype=src.dtype)
    return out.index_add_(0, seg, src)
def _pad(x, pw):
    flat = tuple(v for pair in reversed(pw) for v in pair)
    return torch.nn.functional.pad(x, flat)

kernel_name = 'gated_mix__sliding_block_cached__sliding_block_cached__decode'

def setup_inputs():

    _w = (lambda a: (lambda t: t.to(torch.bfloat16) if t.is_floating_point() else t)(torch.as_tensor(a)))
    def _A_setup():
        B, Sq, D = 2, 1, 1024
        Hq, Hkv, Sk, Dh = 32, 4, 32768, 128
        assert Hq % Hkv == 0, (Hq, Hkv)
        return {
            "x": _w((lambda *s: torch.randn(*s, dtype=torch.bfloat16) * 0.05)(B, Sq, D)),
            "k_cache": _w((lambda *s: torch.randn(*s, dtype=torch.bfloat16) * 6.4)(B, Hkv, Sk, Dh)),
            "v_cache": _w((lambda *s: torch.randn(*s, dtype=torch.bfloat16) * 0.05)(B, Hkv, Sk, Dh)),
            "wq": _w((lambda *s: torch.randn(*s, dtype=torch.bfloat16) * 6.4)(D, Hq * Dh) * (D ** -0.5)),
            "wo": _w((lambda *s: torch.randn(*s, dtype=torch.bfloat16) * 0.05)(Hq * Dh, D) * ((Hq * Dh) ** -0.5)),
        }
    _A_in = _A_setup()

    def _B_setup():
        B, Sq, D = 2, 1, 1024
        Hq, Hkv, Sk, Dh = 32, 4, 32768, 128
        assert Hq % Hkv == 0, (Hq, Hkv)
        return {
            "x": _w((lambda *s: torch.randn(*s, dtype=torch.bfloat16) * 0.05)(B, Sq, D)),
            "k_cache": _w((lambda *s: torch.randn(*s, dtype=torch.bfloat16) * 6.4)(B, Hkv, Sk, Dh)),
            "v_cache": _w((lambda *s: torch.randn(*s, dtype=torch.bfloat16) * 0.05)(B, Hkv, Sk, Dh)),
            "wq": _w((lambda *s: torch.randn(*s, dtype=torch.bfloat16) * 6.4)(D, Hq * Dh) * (D ** -0.5)),
            "wo": _w((lambda *s: torch.randn(*s, dtype=torch.bfloat16) * 0.05)(Hq * Dh, D) * ((Hq * Dh) ** -0.5)),
        }
    _B_in = _B_setup()

    return {
        "A_x": _A_in["x"],
        "A_k_cache": _A_in["k_cache"],
        "A_v_cache": _A_in["v_cache"],
        "A_wq": _A_in["wq"],
        "A_wo": _A_in["wo"],
        "B_x": _B_in["x"],
        "B_k_cache": _B_in["k_cache"],
        "B_v_cache": _B_in["v_cache"],
        "B_wq": _B_in["wq"],
        "B_wo": _B_in["wo"],
        "gate_w": _w((lambda *s: torch.randn(*s, dtype=torch.bfloat16) * 0.05)(1024) * 16.0),
    }

def reference(A_x, A_k_cache, A_v_cache, A_wq, A_wo, B_x, B_k_cache, B_v_cache, B_wq, B_wo, gate_w):
    def _A_ref(x, k_cache, v_cache, wq, wo):
        B, Sq, D = x.shape
        Hq, Dh = 32, 128
        Hkv, Sk = k_cache.shape[1], k_cache.shape[2]
        W = min(4096, max(256, Sk // 4))
        rep = Hq // Hkv
        q = (lambda x, *d: x.permute(*d))((x @ wq).reshape(B, Sq, Hq, Dh), 0, 2, 1, 3)
        k = (lambda x, n, axis: torch.repeat_interleave(x, n, dim=axis))(k_cache[:, :, Sk - W:, :], rep, axis=1)
        v = (lambda x, n, axis: torch.repeat_interleave(x, n, dim=axis))(v_cache[:, :, Sk - W:, :], rep, axis=1)
        scores = torch.einsum("bhqd,bhkd->bhqk", q, k) * (Dh ** -0.5)
        p = _softmax(scores, axis=-1)
        o = torch.einsum("bhqk,bhkd->bhqd", p, v)
        return (lambda x, *d: x.permute(*d))(o, 0, 2, 1, 3).reshape(B, Sq, Hq * Dh) @ wo

    def _B_ref(x, k_cache, v_cache, wq, wo):
        B, Sq, D = x.shape
        Hq, Dh = 32, 128
        Hkv, Sk = k_cache.shape[1], k_cache.shape[2]
        W = min(4096, max(256, Sk // 4))
        rep = Hq // Hkv
        q = (lambda x, *d: x.permute(*d))((x @ wq).reshape(B, Sq, Hq, Dh), 0, 2, 1, 3)
        k = (lambda x, n, axis: torch.repeat_interleave(x, n, dim=axis))(k_cache[:, :, Sk - W:, :], rep, axis=1)
        v = (lambda x, n, axis: torch.repeat_interleave(x, n, dim=axis))(v_cache[:, :, Sk - W:, :], rep, axis=1)
        scores = torch.einsum("bhqd,bhkd->bhqk", q, k) * (Dh ** -0.5)
        p = _softmax(scores, axis=-1)
        o = torch.einsum("bhqk,bhkd->bhqd", p, v)
        return (lambda x, *d: x.permute(*d))(o, 0, 2, 1, 3).reshape(B, Sq, Hq * Dh) @ wo

    x = A_x
    g = _sigmoid((x * gate_w).sum(-1, keepdims=True))
    a = _A_ref(x, A_k_cache, A_v_cache, A_wq, A_wo)
    b = _B_ref(x, B_k_cache, B_v_cache, B_wq, B_wo)
    return g * a + (1 - g) * b
```

```asm
; @launch grid=(256,1,1) block=(512,1,1) lds=155648
.amdgcn_target "amdgcn-amd-amdhsa--gfx950"
.text
.globl gated_mix__sliding_block_cached__sliding_block_cached__decode_kernel
.p2align 8
.type gated_mix__sliding_block_cached__sliding_block_cached__decode_kernel,@function
gated_mix__sliding_block_cached__sliding_block_cached__decode_kernel:
s_cmp_ge_u32 s2, 0x100
s_cbranch_scc1 L_end
s_load_dwordx16 s[4:19], s[0:1], 0
s_load_dwordx8 s[20:27], s[0:1], 64
s_load_dwordx2 s[28:29], s[0:1], 104
v_lshrrev_b32 v1, 6, v0
v_and_b32 v2, 15, v0
v_readfirstlane_b32 s64, v1
v_and_b32 v1, 63, v0
v_lshrrev_b32 v3, 4, v1
s_and_b32 s65, s2, 7
s_lshr_b32 s66, s2, 3
s_and_b32 s67, s65, 1
s_lshr_b32 s68, s65, 1
s_lshr_b32 s69, s66, 2
s_and_b32 s70, s66, 3
s_lshr_b32 s71, s66, 4
s_and_b32 s72, s66, 15
s_xor_b32 s30, s64, s66
s_xor_b32 s30, s30, s65
s_lshr_b32 s86, s66, 3
s_xor_b32 s30, s30, s86
s_and_b32 s30, s30, 7
v_lshlrev_b32 v84, 16, v3
v_lshl_add_u32 v84, v2, 4, v84
s_lshl_b32 s86, s70, 8
s_lshl_b32 s87, s64, 5
s_add_u32 s88, s86, s87
s_lshl_b32 s73, s88, 13
s_lshl_b32 s86, s68, 11
s_lshl_b32 s87, s69, 8
s_add_u32 s73, s73, s86
s_add_u32 s73, s73, s87
s_lshl_b32 s86, s30, 13
s_add_u32 s73, s73, s86
v_and_b32 v251, 7, v2
v_xor_b32 v251, s30, v251
v_lshlrev_b32 v251, 1, v251
v_lshl_add_u32 v251, v3, 4, v251
v_lshrrev_b32 v252, 3, v2
v_lshl_add_u32 v251, v252, 11, v251
s_lshl_b32 s88, s88, 1
s_sub_u32 s83, s2, 64
v_lshlrev_b32 v99, 4, v1
s_waitcnt lgkmcnt(0)
s_cmp_eq_u32 s67, 0
s_cselect_b32 s40, s10, s20
s_cselect_b32 s41, s11, s21
s_mov_b32 s42, 0x800000
s_mov_b32 s43, 0x20000
s_mov_b32 s48, s4
s_mov_b32 s49, s5
s_mov_b32 s50, 0x1000
s_mov_b32 s51, 0x20000
s_load_dword s77, s[28:29], 0
s_cmp_lg_u32 s64, 2
s_cbranch_scc1 L_nogate
s_cmp_ge_u32 s83, 64
s_cbranch_scc1 L_nogate
s_mov_b32 s60, s24
s_mov_b32 s61, s25
s_mov_b32 s62, 0x800
s_mov_b32 s63, 0x20000
s_lshr_b32 s86, s83, 5
s_lshl_b32 s86, s86, 11
v_lshlrev_b32 v252, 5, v1
buffer_load_dwordx4 v[232:235], v252, s[48:51], s86 offen
buffer_load_dwordx4 v[236:239], v252, s[48:51], s86 offen offset:16
buffer_load_dwordx4 v[240:243], v252, s[60:63], 0 offen
buffer_load_dwordx4 v[244:247], v252, s[60:63], 0 offen offset:16
L_nogate:
buffer_load_ushort v12, v251, s[48:51], s88 offen
s_xor_b32 s31, s73, 0x0
buffer_load_dwordx4 v[48:51], v84, s[40:43], s31 offen nt
s_xor_b32 s31, s73, 0x2000
buffer_load_dwordx4 v[52:55], v84, s[40:43], s31 offen nt
s_xor_b32 s31, s73, 0x4000
buffer_load_dwordx4 v[56:59], v84, s[40:43], s31 offen nt
s_cmp_eq_u32 s67, 0
s_cselect_b32 s32, s6, s16
s_cselect_b32 s33, s7, s17
s_cselect_b32 s36, s8, s18
s_cselect_b32 s37, s9, s19
s_cselect_b32 s44, s12, s22
s_cselect_b32 s45, s13, s23
s_mov_b32 s34, 0x4000000
s_mov_b32 s35, 0x20000
s_mov_b32 s38, 0x4000000
s_mov_b32 s39, 0x20000
s_mov_b32 s46, 0x800000
s_mov_b32 s47, 0x20000
s_mov_b32 s52, s28
s_mov_b32 s53, s29
s_mov_b32 s54, 0x250000
s_mov_b32 s55, 0x20000
s_mov_b32 s56, s26
s_mov_b32 s57, s27
s_mov_b32 s58, 0x1000
s_mov_b32 s59, 0x20000
s_lshl_b32 s86, s71, 2
s_add_u32 s86, s86, s68
s_lshl_b32 s74, s86, 23
s_lshl_b32 s86, s72, 16
s_add_u32 s74, s74, s86
s_lshl_b32 s89, s64, 13
s_add_u32 s74, s74, s89
s_add_u32 s74, s74, 0x700000
s_lshl_b32 s86, s30, 10
s_add_u32 s74, s74, s86
s_add_u32 s75, s89, s86
s_add_u32 s101, s75, 65536
s_lshl_b32 s86, s68, 10
s_lshl_b32 s87, s69, 7
s_add_u32 s86, s86, s87
s_lshr_b32 s87, s64, 1
s_lshl_b32 s87, s87, 5
s_add_u32 s86, s86, s87
s_lshl_b32 s76, s86, 11
s_lshl_b32 s86, s70, 9
s_add_u32 s76, s76, s86
s_and_b32 s86, s64, 1
s_lshl_b32 s86, s86, 8
s_add_u32 s76, s76, s86
s_lshl_b32 s86, s30, 11
s_add_u32 s76, s76, s86
v_lshlrev_b32 v85, 14, v3
v_lshl_add_u32 v85, v2, 4, v85
s_lshl_b32 s86, s65, 15
s_lshl_b32 s87, s69, 11
s_add_u32 s87, s87, s86
s_lshl_b32 s88, s70, 9
s_add_u32 s87, s87, s88
s_add_u32 s4, s87, 0x40000
s_add_u32 s5, s87, 0x80000
s_lshl_b32 s87, s71, 14
s_add_u32 s86, s86, s87
s_lshl_b32 s87, s64, 11
s_add_u32 s86, s86, s87
s_add_u32 s6, s86, 0x40000
s_add_u32 s7, s86, 0x80000
s_xor_b32 s7, s7, s6
s_lshl_b32 s86, s65, 17
s_lshl_b32 s87, s66, 9
s_add_u32 s86, s86, s87
s_lshl_b32 s87, s64, 6
s_add_u32 s86, s86, s87
s_add_u32 s8, s86, 0xc0000
s_lshl_b32 s86, s65, 12
s_lshl_b32 s87, s66, 4
s_add_u32 s86, s86, s87
s_add_u32 s9, s86, 0x1c0000
s_lshl_b32 s86, s65, 3
s_add_u32 s86, s86, s69
s_lshl_b32 s87, s86, 9
s_add_u32 s11, s87, 0x1c0000
s_lshl_b32 s86, s86, 14
s_lshl_b32 s87, s64, 11
s_add_u32 s86, s86, s87
s_add_u32 s10, s86, 0xc0000
s_lshl_b32 s86, s70, 16
s_lshl_b32 s87, s64, 15
s_add_u32 s86, s86, s87
s_lshl_b32 s87, s67, 12
s_add_u32 s86, s86, s87
s_lshl_b32 s87, s68, 10
s_add_u32 s86, s86, s87
s_lshl_b32 s87, s69, 7
s_add_u32 s86, s86, s87
s_add_u32 s12, s86, 0x1d0000
s_lshl_b32 s86, s83, 13
s_lshl_b32 s87, s64, 10
s_add_u32 s86, s86, s87
s_add_u32 s13, s86, 0x1d0000
s_mov_b32 s14, 0
s_mov_b32 s15, 0
s_lshl_b32 s86, s64, 3
s_lshl_b64 s[16:17], 0xff, s86
s_mov_b32 s18, 0x00ff00ff
s_mov_b32 s19, 0x00ff00ff
s_mov_b32 s94, 0xff00ff00
s_mov_b32 s95, 0xff00ff00
s_getreg_b32 s91, hwreg(HW_REG_XCC_ID, 0, 4)
v_xor_b32 v251, v2, v3
v_lshlrev_b32 v251, 4, v251
v_lshlrev_b32 v252, 8, v3
s_and_b32 s86, s30, 3
s_lshl_b32 s86, s86, 6
v_xor_b32 v168, s86, v251
v_xor_b32 v86, 0, v168
v_add_u32 v86, v86, v252
v_xor_b32 v87, 64, v168
v_add_u32 v87, v87, v252
v_xor_b32 v88, 128, v168
v_add_u32 v88, v88, v252
v_xor_b32 v89, 192, v168
v_add_u32 v89, v89, v252
v_lshlrev_b32 v168, 8, v2
v_add_u32 v168, s89, v168
v_xor_b32 v92, 0, v251
v_add_u32 v92, v92, v168
v_xor_b32 v93, 64, v251
v_add_u32 v93, v93, v168
v_xor_b32 v94, 128, v251
v_add_u32 v94, v94, v168
v_xor_b32 v95, 192, v251
v_add_u32 v95, v95, v168
v_lshrrev_b32 v168, 1, v2
v_xor_b32 v168, v168, v3
v_lshlrev_b32 v168, 5, v168
v_and_b32 v169, 1, v2
v_lshl_add_u32 v169, v169, 4, v252
s_and_b32 s86, s30, 1
s_lshl_b32 s86, s86, 7
v_xor_b32 v168, s86, v168
v_add_u32 v90, v168, v169
v_xor_b32 v168, 128, v168
v_add_u32 v91, v168, v169
v_lshrrev_b32 v168, 2, v1
v_and_b32 v169, 7, v168
v_xor_b32 v169, s64, v169
v_lshlrev_b32 v169, 5, v169
v_lshl_add_u32 v168, v168, 8, v169
v_and_b32 v169, 3, v1
v_lshl_add_u32 v168, v169, 3, v168
v_add_u32 v97, 65536, v168
v_and_b32 v170, 7, v2
v_lshrrev_b32 v171, 3, v2
v_mul_u32_u24 v168, 272, v170
v_lshl_add_u32 v168, v3, 4, v168
v_add_u32 v96, 151680, v168
s_lshl_b32 s86, s64, 10
v_add_u32 v98, s86, v99
v_add_u32 v254, 131072, v98
v_add_u32 v98, 139264, v98
v_lshlrev_b32 v184, 14, v171
v_lshl_add_u32 v184, v3, 7, v184
v_lshl_add_u32 v184, v170, 4, v184
v_bfe_u32 v168, v1, 3, 2
v_lshlrev_b32 v168, 6, v168
v_lshl_add_u32 v168, v170, 1, v168
v_lshrrev_b32 v169, 5, v1
v_lshl_add_u32 v168, v169, 5, v168
s_mul_i32 s86, s64, 272
s_add_u32 s86, s86, 151680
v_add_u32 v185, s86, v168
v_and_b32 v168, 31, v1
v_lshlrev_b32 v168, 4, v168
v_lshl_add_u32 v168, v169, 3, v168
s_lshl_b32 s86, s64, 9
s_lshr_b32 s87, s64, 2
s_lshl_b32 s87, s87, 6
s_add_u32 s86, s86, s87
s_add_u32 s86, s86, 147456
v_add_u32 v191, s86, v168
v_xor_b32 v168, s30, v170
v_lshlrev_b32 v168, 2, v168
v_lshl_add_u32 v168, v3, 5, v168
v_mul_u32_u24 v251, 2112, v171
v_add_u32 v168, v168, v251
s_lshr_b32 s86, s64, 1
s_lshl_b32 s86, s86, 7
s_add_u32 s86, s86, 147456
v_add_u32 v248, s86, v168
v_lshlrev_b32 v186, 5, v170
v_add_u32 v186, 153856, v186
s_lshl_b32 s86, s64, 2
v_add_u32 v187, s86, v186
v_lshlrev_b32 v188, 14, v2
v_lshl_add_u32 v188, v3, 4, v188
v_lshlrev_b32 v189, 9, v2
s_and_b32 s86, s64, 3
s_lshl_b32 s86, s86, 2
v_add_u32 v190, s86, v2
v_and_b32 v190, 15, v190
s_lshr_b32 s86, s64, 2
s_lshl_b32 s86, s86, 4
v_add_u32 v190, s86, v190
v_lshlrev_b32 v190, 4, v190
v_lshlrev_b32 v249, 18, v171
v_lshl_add_u32 v249, v3, 13, v249
v_lshl_add_u32 v249, v170, 4, v249
v_and_b32 v168, 1, v3
v_lshrrev_b32 v169, 1, v3
v_lshl_add_u32 v168, v168, 1, v169
v_lshl_add_u32 v168, v168, 3, v170
v_lshlrev_b32 v168, 5, v168
s_lshl_b32 s86, s64, 2
s_add_u32 s86, s86, 154368
v_add_u32 v255, s86, v168
v_mov_b32 v169, 0x0c0c0100
v_mov_b32 v170, 0x0c0c0302
v_cndmask_b32 v169, v169, v170, s[94:95]
v_and_b32 v168, 1, v2
v_cmp_eq_u32 vcc, 1, v168
v_alignbit_b32 v170, v169, v169, 16
v_mov_b32 v173, 0x0c0c0c0c
v_cndmask_b32 v169, v169, v170, vcc
v_bfe_u32 v168, v2, 1, 2
v_cmp_eq_u32 vcc, 0, v168
s_nop 1
v_cndmask_b32 v4, v173, v169, vcc
v_cmp_eq_u32 vcc, 1, v168
s_nop 1
v_cndmask_b32 v5, v173, v169, vcc
v_cmp_eq_u32 vcc, 2, v168
s_nop 1
v_cndmask_b32 v6, v173, v169, vcc
v_cmp_eq_u32 vcc, 3, v168
s_nop 1
v_cndmask_b32 v7, v173, v169, vcc
s_mov_b32 s24, 0x05040100
s_mov_b32 s79, 0x7060500
s_mov_b32 s80, 0x7060501
s_mov_b32 s81, 0x7060502
s_mov_b32 s82, 0x7060503
s_mov_b32 s90, 0x3fb8aa3b
s_mov_b32 s98, 0x3db504f3
s_mov_b32 s99, 0x3db504f3
s_mov_b32 s85, 1000000
s_waitcnt vmcnt(3)
v_mov_b32_dpp v9, v12 row_ror:8 row_mask:0xf bank_mask:0xf
v_perm_b32 v8, v9, v12, s24
s_nop 1
v_mov_b32_dpp v9, v8 row_newbcast:0 row_mask:0xf bank_mask:0xf
v_perm_b32 v16, v9, v9, v4
v_perm_b32 v17, v9, v9, v5
v_perm_b32 v18, v9, v9, v6
v_perm_b32 v19, v9, v9, v7
v_mov_b32_dpp v10, v8 row_newbcast:1 row_mask:0xf bank_mask:0xf
v_perm_b32 v20, v10, v10, v4
v_perm_b32 v21, v10, v10, v5
v_perm_b32 v22, v10, v10, v6
v_perm_b32 v23, v10, v10, v7
v_mov_b32_dpp v9, v8 row_newbcast:2 row_mask:0xf bank_mask:0xf
v_perm_b32 v24, v9, v9, v4
v_perm_b32 v25, v9, v9, v5
v_perm_b32 v26, v9, v9, v6
v_perm_b32 v27, v9, v9, v7
v_mov_b32_dpp v10, v8 row_newbcast:3 row_mask:0xf bank_mask:0xf
v_perm_b32 v28, v10, v10, v4
v_perm_b32 v29, v10, v10, v5
v_perm_b32 v30, v10, v10, v6
v_perm_b32 v31, v10, v10, v7
v_mov_b32_dpp v9, v8 row_newbcast:4 row_mask:0xf bank_mask:0xf
v_perm_b32 v32, v9, v9, v4
v_perm_b32 v33, v9, v9, v5
v_perm_b32 v34, v9, v9, v6
v_perm_b32 v35, v9, v9, v7
v_mov_b32_dpp v10, v8 row_newbcast:5 row_mask:0xf bank_mask:0xf
v_perm_b32 v36, v10, v10, v4
v_perm_b32 v37, v10, v10, v5
v_perm_b32 v38, v10, v10, v6
v_perm_b32 v39, v10, v10, v7
v_mov_b32_dpp v9, v8 row_newbcast:6 row_mask:0xf bank_mask:0xf
v_perm_b32 v40, v9, v9, v4
v_perm_b32 v41, v9, v9, v5
v_perm_b32 v42, v9, v9, v6
v_perm_b32 v43, v9, v9, v7
v_mov_b32_dpp v10, v8 row_newbcast:7 row_mask:0xf bank_mask:0xf
v_perm_b32 v44, v10, v10, v4
v_perm_b32 v45, v10, v10, v5
v_perm_b32 v46, v10, v10, v6
v_perm_b32 v47, v10, v10, v7
s_waitcnt vmcnt(2)
s_xor_b32 s31, s73, 0x6000
buffer_load_dwordx4 v[60:63], v84, s[40:43], s31 offen nt
v_mfma_f32_16x16x32_bf16 v[80:83], v[48:51], v[16:19], 0
s_waitcnt lgkmcnt(0)
s_mul_i32 s77, s77, 1664525
s_add_u32 s77, s77, 1013904223
s_and_b32 s78, s77, 0xffffff7f
s_or_b32 s78, s78, 0x8000
v_mov_b32 v228, s78
s_bfe_u32 s20, s78, 0x80000
s_bfe_u32 s21, s78, 0x80008
s_bfe_u32 s22, s78, 0x80010
s_bfe_u32 s23, s78, 0x80018
s_xor_b32 s25, s20, s91
s_xor_b32 s26, s21, s91
s_xor_b32 s27, s22, s91
s_xor_b32 s3, s23, s91
s_mul_i32 s87, s91, 0x01010101
s_xor_b32 s87, s87, s78
v_mov_b32 v253, s87
s_waitcnt vmcnt(2)
s_xor_b32 s31, s73, 0x8000
buffer_load_dwordx4 v[64:67], v84, s[40:43], s31 offen nt
v_mfma_f32_16x16x32_bf16 v[80:83], v[52:55], v[20:23], v[80:83]
s_waitcnt vmcnt(2)
s_xor_b32 s31, s73, 0xa000
buffer_load_dwordx4 v[68:71], v84, s[40:43], s31 offen nt
v_mfma_f32_16x16x32_bf16 v[80:83], v[56:59], v[24:27], v[80:83]
s_waitcnt vmcnt(2)
s_xor_b32 s31, s73, 0xc000
buffer_load_dwordx4 v[72:75], v84, s[40:43], s31 offen nt
v_mfma_f32_16x16x32_bf16 v[80:83], v[60:63], v[28:31], v[80:83]
s_waitcnt vmcnt(2)
s_xor_b32 s31, s73, 0xe000
buffer_load_dwordx4 v[76:79], v84, s[40:43], s31 offen nt
v_mfma_f32_16x16x32_bf16 v[80:83], v[64:67], v[32:35], v[80:83]
s_waitcnt vmcnt(2)
s_barrier
s_xor_b32 m0, s75, 0x0
s_xor_b32 s31, s74, 0x0
buffer_load_dwordx4 v86, s[32:35], s31 offen nt lds
v_mfma_f32_16x16x32_bf16 v[80:83], v[68:71], v[36:39], v[80:83]
s_waitcnt vmcnt(2)
s_barrier
s_xor_b32 m0, s75, 0x400
s_xor_b32 s31, s74, 0x400
buffer_load_dwordx4 v87, s[32:35], s31 offen nt lds
v_mfma_f32_16x16x32_bf16 v[80:83], v[72:75], v[40:43], v[80:83]
s_waitcnt vmcnt(2)
s_barrier
s_xor_b32 m0, s75, 0x800
s_xor_b32 s31, s74, 0x800
buffer_load_dwordx4 v88, s[32:35], s31 offen nt lds
v_mfma_f32_16x16x32_bf16 v[80:83], v[76:79], v[44:47], v[80:83]
s_nop 7
ds_write_b128 v254, v[80:83]
s_waitcnt lgkmcnt(0)
s_barrier
s_mov_b64 exec, s[16:17]
v_add_u32 v168, 131072, v99
ds_read_b128 v[128:131], v168 offset:0
ds_read_b128 v[132:135], v168 offset:1024
ds_read_b128 v[136:139], v168 offset:2048
ds_read_b128 v[140:143], v168 offset:3072
ds_read_b128 v[144:147], v168 offset:4096
ds_read_b128 v[148:151], v168 offset:5120
ds_read_b128 v[152:155], v168 offset:6144
ds_read_b128 v[156:159], v168 offset:7168
s_waitcnt lgkmcnt(0)
v_pk_add_f32 v[128:129], v[128:129], v[132:133]
v_pk_add_f32 v[130:131], v[130:131], v[134:135]
v_pk_add_f32 v[136:137], v[136:137], v[140:141]
v_pk_add_f32 v[138:139], v[138:139], v[142:143]
v_pk_add_f32 v[144:145], v[144:145], v[148:149]
v_pk_add_f32 v[146:147], v[146:147], v[150:151]
v_pk_add_f32 v[152:153], v[152:153], v[156:157]
v_pk_add_f32 v[154:155], v[154:155], v[158:159]
v_pk_add_f32 v[128:129], v[128:129], v[136:137]
v_pk_add_f32 v[130:131], v[130:131], v[138:139]
v_pk_add_f32 v[144:145], v[144:145], v[152:153]
v_pk_add_f32 v[146:147], v[146:147], v[154:155]
v_pk_add_f32 v[224:225], v[128:129], v[144:145]
v_pk_add_f32 v[226:227], v[130:131], v[146:147]
v_perm_b32 v172, v224, v253, s79
v_perm_b32 v173, v225, v253, s80
v_perm_b32 v174, v226, v253, s81
v_perm_b32 v175, v227, v253, s82
buffer_store_dwordx4 v[172:175], v184, s[52:55], s4 offen
v_perm_b32 v224, v224, v228, s79
v_perm_b32 v225, v225, v228, s80
v_perm_b32 v226, v226, v228, s81
v_perm_b32 v227, v227, v228, s82
v_add_u32 v168, 154368, v99
ds_write_b128 v168, v[224:227]
s_mov_b64 exec, -1
s_waitcnt lgkmcnt(0)
s_waitcnt vmcnt(3)
s_barrier
s_xor_b32 m0, s75, 0xc00
s_xor_b32 s31, s74, 0xc00
buffer_load_dwordx4 v89, s[32:35], s31 offen nt lds
s_waitcnt vmcnt(3)
s_barrier
s_xor_b32 m0, s75, 0x1000
s_xor_b32 s31, s74, 0x1000
buffer_load_dwordx4 v86, s[32:35], s31 offen nt lds
s_waitcnt vmcnt(3)
s_barrier
s_xor_b32 m0, s75, 0x1400
s_xor_b32 s31, s74, 0x1400
buffer_load_dwordx4 v87, s[32:35], s31 offen nt lds
s_waitcnt vmcnt(2)
s_barrier
s_xor_b32 m0, s75, 0x1800
s_xor_b32 s31, s74, 0x1800
buffer_load_dwordx4 v88, s[32:35], s31 offen nt lds
s_waitcnt vmcnt(2)
s_barrier
s_xor_b32 m0, s75, 0x1c00
s_xor_b32 s31, s74, 0x1c00
buffer_load_dwordx4 v89, s[32:35], s31 offen nt lds
s_waitcnt vmcnt(2)
s_barrier
buffer_load_dwordx4 v[100:103], v99, s[52:55], s6 offen sc1
buffer_load_dwordx4 v[104:107], v99, s[52:55], s6 offen offset:1024 sc1
s_xor_b32 m0, s101, 0x0
s_xor_b32 s31, s74, 0x0
buffer_load_dwordx4 v90, s[36:39], s31 offen nt lds
s_waitcnt vmcnt(4)
s_barrier
s_xor_b32 m0, s101, 0x400
s_xor_b32 s31, s74, 0x400
buffer_load_dwordx4 v91, s[36:39], s31 offen nt lds
s_waitcnt vmcnt(4)
s_barrier
s_xor_b32 m0, s101, 0x800
s_xor_b32 s31, s74, 0x800
buffer_load_dwordx4 v90, s[36:39], s31 offen nt lds
ds_read_b128 v[128:131], v92 offset:0
ds_read_b128 v[132:135], v93 offset:0
ds_read_b128 v[136:139], v94 offset:0
ds_read_b128 v[140:143], v95 offset:0
ds_read_b128 v[144:147], v92 offset:4096
ds_read_b128 v[148:151], v93 offset:4096
ds_read_b128 v[152:155], v94 offset:4096
ds_read_b128 v[156:159], v95 offset:4096
s_waitcnt vmcnt(3)
L_g1_chk:
v_xor_b32 v100, s25, v100
v_xor_b32 v101, s26, v101
v_xor_b32 v102, s27, v102
v_xor_b32 v103, s3, v103
v_xor_b32 v104, s25, v104
v_xor_b32 v105, s26, v105
v_xor_b32 v106, s27, v106
v_xor_b32 v107, s3, v107
v_or3_b32 v168, v100, v101, v102
v_or3_b32 v168, v168, v103, v104
v_or3_b32 v168, v168, v105, v106
v_or_b32 v168, v168, v107
v_and_b32 v168, 0xff, v168
v_cmp_ne_u32 vcc, 0, v168
s_nop 0
s_cbranch_vccz L_g1_ok
s_sub_u32 s85, s85, 1
s_cbranch_scc1 L_end
s_cmp_lg_u32 s15, 0
s_cbranch_scc1 L_g1_pubd
v_add_u32 v251, 154368, v99
ds_read_b128 v[172:175], v251
s_waitcnt lgkmcnt(0)
buffer_store_dwordx4 v[172:175], v184, s[52:55], s5 offen sc1
s_mov_b32 s15, 1
L_g1_pubd:
s_xor_b32 s6, s6, s7
s_xor_b32 s25, s25, s91
s_xor_b32 s26, s26, s91
s_xor_b32 s27, s27, s91
s_xor_b32 s3, s3, s91
s_xor_b32 s14, s14, 1
buffer_load_dwordx4 v[100:103], v99, s[52:55], s6 offen sc1
buffer_load_dwordx4 v[104:107], v99, s[52:55], s6 offen offset:1024 sc1
s_waitcnt vmcnt(0)
s_branch L_g1_chk
L_g1_ok:
s_xor_b32 s86, s14, 1
v_mov_b32 v170, s86
s_lshl_b32 s86, s64, 2
s_add_u32 s86, s86, 155392
v_mov_b32 v171, s86
ds_write_b32 v171, v170
v_pk_add_f32 v[100:101], v[100:101], v[104:105]
v_pk_add_f32 v[102:103], v[102:103], v[106:107]
s_nop 1
v_permlane32_swap_b32 v100, v102
v_permlane32_swap_b32 v101, v103
v_add_f32 v100, v100, v102
v_add_f32 v101, v101, v103
v_cvt_pk_bf16_f32 v100, v100, v101
ds_write_b16 v185, v100
ds_write_b16_d16_hi v185, v100 offset:16
s_waitcnt lgkmcnt(0)
s_barrier
ds_read_b128 v[112:115], v96 offset:0
ds_read_b128 v[116:119], v96 offset:64
ds_read_b128 v[120:123], v96 offset:128
ds_read_b128 v[124:127], v96 offset:192
v_mov_b32 v171, 155392
ds_read_b128 v[176:179], v171
ds_read_b128 v[180:183], v171 offset:16
s_xor_b32 m0, s101, 0xc00
s_xor_b32 s31, s74, 0xc00
buffer_load_dwordx4 v91, s[36:39], s31 offen nt lds
s_xor_b32 m0, s101, 0x1000
s_xor_b32 s31, s74, 0x1000
buffer_load_dwordx4 v90, s[36:39], s31 offen nt lds
s_xor_b32 m0, s101, 0x1400
s_xor_b32 s31, s74, 0x1400
buffer_load_dwordx4 v91, s[36:39], s31 offen nt lds
s_waitcnt lgkmcnt(5)
v_mfma_f32_16x16x32_bf16 v[160:163], v[128:131], v[112:115], 0
v_mfma_f32_16x16x32_bf16 v[164:167], v[144:147], v[112:115], 0
s_waitcnt lgkmcnt(4)
v_mfma_f32_16x16x32_bf16 v[160:163], v[132:135], v[116:119], v[160:163]
v_mfma_f32_16x16x32_bf16 v[164:167], v[148:151], v[116:119], v[164:167]
s_waitcnt lgkmcnt(3)
v_mfma_f32_16x16x32_bf16 v[160:163], v[136:139], v[120:123], v[160:163]
v_mfma_f32_16x16x32_bf16 v[164:167], v[152:155], v[120:123], v[164:167]
s_waitcnt lgkmcnt(2)
v_mfma_f32_16x16x32_bf16 v[160:163], v[140:143], v[124:127], v[160:163]
v_mfma_f32_16x16x32_bf16 v[164:167], v[156:159], v[124:127], v[164:167]
s_waitcnt lgkmcnt(0)
v_and_b32 v176, v176, v177
v_and_b32 v178, v178, v179
v_and_b32 v180, v180, v181
v_and_b32 v182, v182, v183
v_and_b32 v176, v176, v178
v_and_b32 v180, v180, v182
v_and_b32 v176, v176, v180
s_nop 0
v_readfirstlane_b32 s100, v176
v_cndmask_b32 v160, v160, v164, s[94:95]
v_cndmask_b32 v161, v161, v165, s[94:95]
v_cndmask_b32 v162, v162, v166, s[94:95]
v_cndmask_b32 v163, v163, v167, s[94:95]
v_cvt_pk_bf16_f32 v168, v160, v161
v_cvt_pk_bf16_f32 v170, v162, v163
v_and_b32 v169, 0xffff0000, v168
v_lshlrev_b32 v168, 16, v168
v_and_b32 v171, 0xffff0000, v170
v_lshlrev_b32 v170, 16, v170
v_pk_mul_f32 v[168:169], v[168:169], s[98:99]
v_pk_mul_f32 v[170:171], v[170:171], s[98:99]
v_cvt_pk_bf16_f32 v168, v168, v169
v_cvt_pk_bf16_f32 v170, v170, v171
v_and_b32 v161, 0xffff0000, v168
v_lshlrev_b32 v160, 16, v168
v_and_b32 v163, 0xffff0000, v170
v_lshlrev_b32 v162, 16, v170
v_max3_f32 v168, v160, v161, v162
v_max_f32 v168, v168, v163
s_nop 1
v_max_f32_dpp v168, v168, v168 row_ror:8 row_mask:0xf bank_mask:0xf
v_mov_b32 v169, v168
s_nop 1
v_permlane16_swap_b32 v168, v169
v_max_f32 v168, v168, v169
v_mov_b32 v169, v168
s_nop 1
v_permlane32_swap_b32 v168, v169
v_max_f32 v168, v168, v169
s_mov_b64 exec, 0xff
ds_write_b32 v187, v168
s_mov_b64 exec, -1
s_waitcnt lgkmcnt(0)
s_barrier
s_xor_b32 m0, s101, 0x1800
s_xor_b32 s31, s74, 0x1800
buffer_load_dwordx4 v90, s[36:39], s31 offen nt lds
s_xor_b32 m0, s101, 0x1c00
s_xor_b32 s31, s74, 0x1c00
buffer_load_dwordx4 v91, s[36:39], s31 offen nt lds
ds_read_b128 v[172:175], v186
ds_read_b128 v[176:179], v186 offset:16
s_waitcnt lgkmcnt(0)
v_max3_f32 v229, v172, v173, v174
v_max3_f32 v172, v175, v176, v177
v_max3_f32 v229, v229, v178, v179
v_max_f32 v229, v229, v172
v_mul_f32 v172, s90, v229
v_fma_f32 v160, v160, s90, -v172
v_fma_f32 v161, v161, s90, -v172
v_fma_f32 v162, v162, s90, -v172
v_fma_f32 v163, v163, s90, -v172
v_exp_f32 v160, v160
v_exp_f32 v161, v161
v_exp_f32 v162, v162
v_exp_f32 v163, v163
v_cvt_pk_bf16_f32 v172, v160, v161
v_cvt_pk_bf16_f32 v173, v162, v163
s_nop 0
v_mov_b32_dpp v174, v172 row_ror:8 row_mask:0xf bank_mask:0xf
v_mov_b32_dpp v175, v173 row_ror:8 row_mask:0xf bank_mask:0xf
ds_write_b128 v98, v[172:175]
v_pk_add_f32 v[160:161], v[160:161], v[162:163]
v_add_f32 v160, v160, v161
s_nop 1
v_add_f32_dpp v160, v160, v160 row_ror:8 row_mask:0xf bank_mask:0xf
v_mov_b32 v161, v160
s_nop 1
v_permlane16_swap_b32 v160, v161
v_add_f32 v160, v160, v161
v_mov_b32 v161, v160
s_nop 1
v_permlane32_swap_b32 v160, v161
v_add_f32 v160, v160, v161
s_mov_b64 exec, 0xff
ds_write_b32 v187, v160 offset:256
s_mov_b64 exec, -1
s_cmp_lg_u32 s64, 2
s_cbranch_scc1 L_nogate2
s_cmp_ge_u32 s83, 64
s_cbranch_scc1 L_nogate2
v_lshlrev_b32 v168, 16, v232
v_lshlrev_b32 v169, 16, v240
v_and_b32 v170, 0xffff0000, v232
v_and_b32 v171, 0xffff0000, v240
v_mul_f32 v168, v168, v169
v_mul_f32 v170, v170, v171
v_cvt_pk_bf16_f32 v168, v168, v170
v_lshlrev_b32 v169, 16, v168
v_and_b32 v170, 0xffff0000, v168
v_add_f32 v172, v169, v170
v_lshlrev_b32 v168, 16, v233
v_lshlrev_b32 v169, 16, v241
v_and_b32 v170, 0xffff0000, v233
v_and_b32 v171, 0xffff0000, v241
v_mul_f32 v168, v168, v169
v_mul_f32 v170, v170, v171
v_cvt_pk_bf16_f32 v168, v168, v170
v_lshlrev_b32 v169, 16, v168
v_and_b32 v170, 0xffff0000, v168
v_add_f32 v172, v172, v169
v_add_f32 v172, v172, v170
v_lshlrev_b32 v168, 16, v234
v_lshlrev_b32 v169, 16, v242
v_and_b32 v170, 0xffff0000, v234
v_and_b32 v171, 0xffff0000, v242
v_mul_f32 v168, v168, v169
v_mul_f32 v170, v170, v171
v_cvt_pk_bf16_f32 v168, v168, v170
v_lshlrev_b32 v169, 16, v168
v_and_b32 v170, 0xffff0000, v168
v_add_f32 v172, v172, v169
v_add_f32 v172, v172, v170
v_lshlrev_b32 v168, 16, v235
v_lshlrev_b32 v169, 16, v243
v_and_b32 v170, 0xffff0000, v235
v_and_b32 v171, 0xffff0000, v243
v_mul_f32 v168, v168, v169
v_mul_f32 v170, v170, v171
v_cvt_pk_bf16_f32 v168, v168, v170
v_lshlrev_b32 v169, 16, v168
v_and_b32 v170, 0xffff0000, v168
v_add_f32 v172, v172, v169
v_add_f32 v172, v172, v170
v_lshlrev_b32 v168, 16, v236
v_lshlrev_b32 v169, 16, v244
v_and_b32 v170, 0xffff0000, v236
v_and_b32 v171, 0xffff0000, v244
v_mul_f32 v168, v168, v169
v_mul_f32 v170, v170, v171
v_cvt_pk_bf16_f32 v168, v168, v170
v_lshlrev_b32 v169, 16, v168
v_and_b32 v170, 0xffff0000, v168
v_add_f32 v172, v172, v169
v_add_f32 v172, v172, v170
v_lshlrev_b32 v168, 16, v237
v_lshlrev_b32 v169, 16, v245
v_and_b32 v170, 0xffff0000, v237
v_and_b32 v171, 0xffff0000, v245
v_mul_f32 v168, v168, v169
v_mul_f32 v170, v170, v171
v_cvt_pk_bf16_f32 v168, v168, v170
v_lshlrev_b32 v169, 16, v168
v_and_b32 v170, 0xffff0000, v168
v_add_f32 v172, v172, v169
v_add_f32 v172, v172, v170
v_lshlrev_b32 v168, 16, v238
v_lshlrev_b32 v169, 16, v246
v_and_b32 v170, 0xffff0000, v238
v_and_b32 v171, 0xffff0000, v246
v_mul_f32 v168, v168, v169
v_mul_f32 v170, v170, v171
v_cvt_pk_bf16_f32 v168, v168, v170
v_lshlrev_b32 v169, 16, v168
v_and_b32 v170, 0xffff0000, v168
v_add_f32 v172, v172, v169
v_add_f32 v172, v172, v170
v_lshlrev_b32 v168, 16, v239
v_lshlrev_b32 v169, 16, v247
v_and_b32 v170, 0xffff0000, v239
v_and_b32 v171, 0xffff0000, v247
v_mul_f32 v168, v168, v169
v_mul_f32 v170, v170, v171
v_cvt_pk_bf16_f32 v168, v168, v170
v_lshlrev_b32 v169, 16, v168
v_and_b32 v170, 0xffff0000, v168
v_add_f32 v172, v172, v169
v_add_f32 v172, v172, v170
s_nop 1
v_add_f32_dpp v172, v172, v172 row_ror:8 row_mask:0xf bank_mask:0xf
s_nop 1
v_add_f32_dpp v172, v172, v172 row_ror:4 row_mask:0xf bank_mask:0xf
s_nop 1
v_add_f32_dpp v172, v172, v172 row_ror:2 row_mask:0xf bank_mask:0xf
s_nop 1
v_add_f32_dpp v172, v172, v172 row_ror:1 row_mask:0xf bank_mask:0xf
v_mov_b32 v168, v172
s_nop 1
v_permlane16_swap_b32 v172, v168
v_add_f32 v172, v172, v168
v_mov_b32 v168, v172
s_nop 1
v_permlane32_swap_b32 v172, v168
v_add_f32 v172, v172, v168
v_cvt_pk_bf16_f32 v172, v172, v172
v_and_b32 v172, 0xffff0000, v172
v_mul_f32 v172, s90, v172
v_exp_f32 v172, -v172
s_nop 0
v_add_f32 v172, 1.0, v172
v_rcp_f32 v172, v172
s_nop 0
v_cvt_pk_bf16_f32 v230, v172, v172
v_and_b32 v230, 0xffff0000, v230
v_sub_f32 v172, 1.0, v230
v_cvt_pk_bf16_f32 v231, v172, v172
v_and_b32 v231, 0xffff0000, v231
L_nogate2:
s_waitcnt vmcnt(2)
s_barrier
s_xor_b32 s31, s76, 0x0
buffer_load_dwordx4 v[48:51], v85, s[44:47], s31 offen nt
s_waitcnt vmcnt(2)
s_barrier
s_xor_b32 s31, s76, 0x800
buffer_load_dwordx4 v[52:55], v85, s[44:47], s31 offen nt
s_waitcnt vmcnt(2)
s_barrier
s_xor_b32 s31, s76, 0x1000
buffer_load_dwordx4 v[56:59], v85, s[44:47], s31 offen nt
s_waitcnt vmcnt(3) lgkmcnt(0)
s_barrier
v_add_u32 v176, 139264, v99
ds_read_b128 v[128:131], v176 offset:0
ds_read_b64_tr_b16 v[192:193], v97 offset:0
ds_read_b64_tr_b16 v[194:195], v97 offset:4096
ds_read_b128 v[132:135], v176 offset:1024
ds_read_b64_tr_b16 v[196:197], v97 offset:8192
ds_read_b64_tr_b16 v[198:199], v97 offset:12288
ds_read_b128 v[136:139], v176 offset:2048
ds_read_b64_tr_b16 v[200:201], v97 offset:16384
ds_read_b64_tr_b16 v[202:203], v97 offset:20480
ds_read_b128 v[140:143], v176 offset:3072
ds_read_b64_tr_b16 v[204:205], v97 offset:24576
ds_read_b64_tr_b16 v[206:207], v97 offset:28672
ds_read_b128 v[144:147], v176 offset:4096
ds_read_b64_tr_b16 v[208:209], v97 offset:32768
ds_read_b64_tr_b16 v[210:211], v97 offset:36864
s_waitcnt lgkmcnt(12)
v_mfma_f32_16x16x32_bf16 v[224:227], v[192:195], v[128:131], 0
ds_read_b128 v[148:151], v176 offset:5120
ds_read_b64_tr_b16 v[212:213], v97 offset:40960
ds_read_b64_tr_b16 v[214:215], v97 offset:45056
s_waitcnt lgkmcnt(12)
v_mfma_f32_16x16x32_bf16 v[224:227], v[196:199], v[132:135], v[224:227]
ds_read_b128 v[152:155], v176 offset:6144
ds_read_b64_tr_b16 v[216:217], v97 offset:49152
ds_read_b64_tr_b16 v[218:219], v97 offset:53248
s_waitcnt lgkmcnt(12)
v_mfma_f32_16x16x32_bf16 v[224:227], v[200:203], v[136:139], v[224:227]
ds_read_b128 v[156:159], v176 offset:7168
ds_read_b64_tr_b16 v[220:221], v97 offset:57344
ds_read_b64_tr_b16 v[222:223], v97 offset:61440
s_waitcnt lgkmcnt(12)
v_mfma_f32_16x16x32_bf16 v[224:227], v[204:207], v[140:143], v[224:227]
s_waitcnt lgkmcnt(9)
v_mfma_f32_16x16x32_bf16 v[224:227], v[208:211], v[144:147], v[224:227]
s_waitcnt lgkmcnt(6)
v_mfma_f32_16x16x32_bf16 v[224:227], v[212:215], v[148:151], v[224:227]
s_waitcnt lgkmcnt(3)
v_mfma_f32_16x16x32_bf16 v[224:227], v[216:219], v[152:155], v[224:227]
s_waitcnt lgkmcnt(0)
v_mfma_f32_16x16x32_bf16 v[224:227], v[220:223], v[156:159], v[224:227]
ds_read_b128 v[172:175], v186 offset:256
ds_read_b128 v[176:179], v186 offset:272
s_nop 5
v_perm_b32 v224, v224, v228, s79
v_perm_b32 v225, v225, v228, s80
v_perm_b32 v226, v226, v228, s81
v_perm_b32 v227, v227, v228, s82
s_mov_b64 exec, s[18:19]
s_cmp_eq_u32 s100, 0
s_cbranch_scc1 L_s2wt
buffer_store_dwordx4 v[224:227], v188, s[52:55], s8 offen
s_branch L_s2done
L_s2wt:
buffer_store_dwordx4 v[224:227], v188, s[52:55], s8 offen sc1
L_s2done:
s_mov_b64 exec, -1
s_waitcnt lgkmcnt(0)
v_pk_add_f32 v[172:173], v[172:173], v[174:175]
v_pk_add_f32 v[176:177], v[176:177], v[178:179]
v_pk_add_f32 v[172:173], v[172:173], v[176:177]
v_add_f32 v173, v172, v173
v_mov_b32 v172, v229
v_mov_b32 v174, v229
v_mov_b32 v175, v173
v_perm_b32 v172, v172, v228, s79
v_perm_b32 v173, v173, v228, s80
v_perm_b32 v174, v174, v228, s81
v_perm_b32 v175, v175, v228, s82
s_lshl_b64 exec, 1, s64
s_cmp_eq_u32 s100, 0
s_cbranch_scc1 L_stwt
buffer_store_dwordx4 v[172:175], v189, s[52:55], s9 offen
s_branch L_stdone
L_stwt:
buffer_store_dwordx4 v[172:175], v189, s[52:55], s9 offen sc1
L_stdone:
s_mov_b64 exec, -1
s_waitcnt vmcnt(4)
s_barrier
s_xor_b32 s31, s76, 0x1800
buffer_load_dwordx4 v[60:63], v85, s[44:47], s31 offen nt
s_waitcnt vmcnt(4)
s_barrier
s_xor_b32 s31, s76, 0x2000
buffer_load_dwordx4 v[64:67], v85, s[44:47], s31 offen nt
s_waitcnt vmcnt(4)
s_barrier
buffer_load_dwordx4 v[108:111], v190, s[52:55], s11 offen sc1
buffer_load_dwordx4 v[100:103], v99, s[52:55], s10 offen sc1
buffer_load_dwordx4 v[104:107], v99, s[52:55], s10 offen offset:1024 sc1
s_xor_b32 s31, s76, 0x2800
buffer_load_dwordx4 v[68:71], v85, s[44:47], s31 offen nt
s_waitcnt vmcnt(5)
s_barrier
s_xor_b32 s31, s76, 0x3000
buffer_load_dwordx4 v[72:75], v85, s[44:47], s31 offen nt
s_waitcnt vmcnt(5)
s_barrier
s_xor_b32 s31, s76, 0x3800
buffer_load_dwordx4 v[76:79], v85, s[44:47], s31 offen nt
s_waitcnt vmcnt(3)
L_g2_chk:
v_xor_b32 v108, s20, v108
v_xor_b32 v109, s21, v109
v_xor_b32 v110, s22, v110
v_xor_b32 v111, s23, v111
v_max_f32_dpp v168, v108, v108 row_ror:8 row_mask:0xf bank_mask:0xf
v_xor_b32 v100, s20, v100
v_xor_b32 v101, s21, v101
v_max_f32_dpp v168, v168, v168 row_ror:4 row_mask:0xf bank_mask:0xf
v_xor_b32 v102, s22, v102
v_xor_b32 v103, s23, v103
v_max_f32_dpp v168, v168, v168 row_ror:2 row_mask:0xf bank_mask:0xf
v_xor_b32 v104, s20, v104
v_xor_b32 v105, s21, v105
v_max_f32_dpp v168, v168, v168 row_ror:1 row_mask:0xf bank_mask:0xf
v_xor_b32 v106, s22, v106
v_xor_b32 v107, s23, v107
v_or3_b32 v169, v108, v109, v110
v_sub_f32 v170, v108, v168
v_or3_b32 v169, v169, v111, v100
v_mul_f32 v170, s90, v170
v_or3_b32 v169, v169, v101, v102
v_exp_f32 v170, v170
v_or3_b32 v169, v169, v103, v104
v_mul_f32 v109, v170, v111
v_or3_b32 v169, v169, v105, v106
v_or_b32 v169, v169, v107
v_add_f32_dpp v109, v109, v109 row_ror:8 row_mask:0xf bank_mask:0xf
v_and_b32 v169, 0xff, v169
v_cmp_ne_u32 vcc, 0, v169
v_add_f32_dpp v109, v109, v109 row_ror:4 row_mask:0xf bank_mask:0xf
s_cbranch_vccz L_g2_ok
s_sub_u32 s85, s85, 1
s_cbranch_scc1 L_end
buffer_load_dwordx4 v[108:111], v190, s[52:55], s11 offen sc1
buffer_load_dwordx4 v[100:103], v99, s[52:55], s10 offen sc1
buffer_load_dwordx4 v[104:107], v99, s[52:55], s10 offen offset:1024 sc1
s_waitcnt vmcnt(0)
s_branch L_g2_chk
L_g2_ok:
s_nop 0
v_add_f32_dpp v109, v109, v109 row_ror:2 row_mask:0xf bank_mask:0xf
s_nop 1
v_add_f32_dpp v109, v109, v109 row_ror:1 row_mask:0xf bank_mask:0xf
v_rcp_f32 v109, v109
s_nop 0
v_mul_f32 v108, v170, v109
s_nop 1
v_mov_b32_dpp v168, v108 row_newbcast:0 row_mask:0x3 bank_mask:0xf
v_mov_b32_dpp v169, v108 row_newbcast:2 row_mask:0x3 bank_mask:0xf
s_nop 0
v_mov_b32_dpp v168, v108 row_newbcast:1 row_mask:0xc bank_mask:0xf
v_mov_b32_dpp v169, v108 row_newbcast:3 row_mask:0xc bank_mask:0xf
v_mul_f32 v100, v168, v100
v_mul_f32 v101, v168, v101
v_mul_f32 v102, v168, v102
v_mul_f32 v103, v168, v103
v_fmac_f32 v100, v169, v104
v_fmac_f32 v101, v169, v105
v_fmac_f32 v102, v169, v106
v_fmac_f32 v103, v169, v107
s_nop 0
v_permlane32_swap_b32 v100, v102
v_permlane32_swap_b32 v101, v103
v_add_f32 v100, v100, v102
v_add_f32 v101, v101, v103
ds_write_b64 v191, v[100:101]
s_waitcnt lgkmcnt(0)
s_barrier
ds_read_b32 v168, v248 offset:0
ds_read_b32 v169, v248 offset:512
ds_read_b32 v170, v248 offset:1024
ds_read_b32 v171, v248 offset:1536
s_waitcnt lgkmcnt(0)
v_add_f32 v168, v168, v169
v_add_f32 v170, v170, v171
v_add_f32 v168, v168, v170
s_nop 1
v_mov_b32_dpp v169, v168 row_ror:8 row_mask:0xf bank_mask:0xf
v_cvt_pk_bf16_f32 v8, v168, v169
s_nop 1
v_mov_b32_dpp v9, v8 row_newbcast:0 row_mask:0xf bank_mask:0xf
v_perm_b32 v16, v9, v9, v4
v_perm_b32 v17, v9, v9, v5
v_perm_b32 v18, v9, v9, v6
v_perm_b32 v19, v9, v9, v7
v_mov_b32_dpp v10, v8 row_newbcast:1 row_mask:0xf bank_mask:0xf
v_perm_b32 v20, v10, v10, v4
v_perm_b32 v21, v10, v10, v5
v_perm_b32 v22, v10, v10, v6
v_perm_b32 v23, v10, v10, v7
s_waitcnt vmcnt(12)
v_mfma_f32_16x16x32_bf16 v[80:83], v[48:51], v[16:19], 0
v_mov_b32_dpp v9, v8 row_newbcast:2 row_mask:0xf bank_mask:0xf
v_perm_b32 v24, v9, v9, v4
v_perm_b32 v25, v9, v9, v5
v_perm_b32 v26, v9, v9, v6
v_perm_b32 v27, v9, v9, v7
s_waitcnt vmcnt(11)
v_mfma_f32_16x16x32_bf16 v[80:83], v[52:55], v[20:23], v[80:83]
v_mov_b32_dpp v10, v8 row_newbcast:3 row_mask:0xf bank_mask:0xf
v_perm_b32 v28, v10, v10, v4
v_perm_b32 v29, v10, v10, v5
v_perm_b32 v30, v10, v10, v6
v_perm_b32 v31, v10, v10, v7
s_waitcnt vmcnt(10)
v_mfma_f32_16x16x32_bf16 v[80:83], v[56:59], v[24:27], v[80:83]
v_mov_b32_dpp v9, v8 row_newbcast:4 row_mask:0xf bank_mask:0xf
v_perm_b32 v32, v9, v9, v4
v_perm_b32 v33, v9, v9, v5
v_perm_b32 v34, v9, v9, v6
v_perm_b32 v35, v9, v9, v7
s_waitcnt vmcnt(7)
v_mfma_f32_16x16x32_bf16 v[80:83], v[60:63], v[28:31], v[80:83]
v_mov_b32_dpp v10, v8 row_newbcast:5 row_mask:0xf bank_mask:0xf
v_perm_b32 v36, v10, v10, v4
v_perm_b32 v37, v10, v10, v5
v_perm_b32 v38, v10, v10, v6
v_perm_b32 v39, v10, v10, v7
s_waitcnt vmcnt(6)
v_mfma_f32_16x16x32_bf16 v[80:83], v[64:67], v[32:35], v[80:83]
v_mov_b32_dpp v9, v8 row_newbcast:6 row_mask:0xf bank_mask:0xf
v_perm_b32 v40, v9, v9, v4
v_perm_b32 v41, v9, v9, v5
v_perm_b32 v42, v9, v9, v6
v_perm_b32 v43, v9, v9, v7
s_waitcnt vmcnt(2)
v_mfma_f32_16x16x32_bf16 v[80:83], v[68:71], v[36:39], v[80:83]
v_mov_b32_dpp v10, v8 row_newbcast:7 row_mask:0xf bank_mask:0xf
v_perm_b32 v44, v10, v10, v4
v_perm_b32 v45, v10, v10, v5
v_perm_b32 v46, v10, v10, v6
v_perm_b32 v47, v10, v10, v7
s_waitcnt vmcnt(1)
v_mfma_f32_16x16x32_bf16 v[80:83], v[72:75], v[40:43], v[80:83]
s_waitcnt vmcnt(0)
v_mfma_f32_16x16x32_bf16 v[80:83], v[76:79], v[44:47], v[80:83]
s_nop 7
ds_write_b128 v254, v[80:83]
s_waitcnt lgkmcnt(0)
s_barrier
s_cmp_ge_u32 s64, 2
s_cbranch_scc1 L_nopub3
ds_read_b128 v[128:131], v254 offset:0
ds_read_b128 v[132:135], v254 offset:2048
ds_read_b128 v[136:139], v254 offset:4096
ds_read_b128 v[140:143], v254 offset:6144
s_waitcnt lgkmcnt(0)
v_pk_add_f32 v[128:129], v[128:129], v[132:133]
v_pk_add_f32 v[130:131], v[130:131], v[134:135]
v_pk_add_f32 v[136:137], v[136:137], v[140:141]
v_pk_add_f32 v[138:139], v[138:139], v[142:143]
v_pk_add_f32 v[172:173], v[128:129], v[136:137]
v_pk_add_f32 v[174:175], v[130:131], v[138:139]
v_perm_b32 v172, v172, v228, s79
v_perm_b32 v173, v173, v228, s80
v_perm_b32 v174, v174, v228, s81
v_perm_b32 v175, v175, v228, s82
buffer_store_dwordx4 v[172:175], v249, s[52:55], s12 offen sc1
L_nopub3:
s_cmp_ge_u32 s83, 64
s_cbranch_scc1 L_fin
v_and_b32 v15, 31, v1
v_lshlrev_b32 v14, 5, v15
v_add_u32 v14, 154368, v14
v_lshlrev_b32 v15, 1, v15
s_lshl_b32 s87, s83, 6
s_lshl_b64 exec, 0xff, 56
buffer_load_dwordx4 v[192:195], v99, s[52:55], s13 offen sc1
L_g3_sen:
s_waitcnt vmcnt(0)
v_xor_b32 v192, s20, v192
v_xor_b32 v193, s21, v193
v_xor_b32 v194, s22, v194
v_xor_b32 v195, s23, v195
v_or3_b32 v168, v192, v193, v194
v_or_b32 v168, v168, v195
v_and_b32 v168, 0xff, v168
v_cmp_ne_u32 vcc, 0, v168
s_nop 0
s_cbranch_vccz L_g3_senok
buffer_load_dwordx4 v[192:195], v99, s[52:55], s13 offen sc1
s_sub_u32 s85, s85, 1
s_cbranch_scc1 L_end
s_branch L_g3_sen
L_g3_senok:
s_mov_b64 exec, -1
buffer_load_dwordx4 v[192:195], v99, s[52:55], s13 offen sc1
L_g3_loop:
s_waitcnt vmcnt(0)
v_xor_b32 v192, s20, v192
v_xor_b32 v193, s21, v193
v_xor_b32 v194, s22, v194
v_xor_b32 v195, s23, v195
v_or3_b32 v168, v192, v193, v194
v_or_b32 v168, v168, v195
v_and_b32 v168, 0xff, v168
v_cmp_ne_u32 vcc, 0, v168
s_nop 0
s_cbranch_vccz L_g3_ok0
buffer_load_dwordx4 v[192:195], v99, s[52:55], s13 offen sc1
s_sub_u32 s85, s85, 1
s_cbranch_scc1 L_end
s_branch L_g3_loop
L_g3_ok0:
v_permlane32_swap_b32 v192, v193
v_permlane32_swap_b32 v194, v195
v_add_f32 v192, v192, v193
v_add_f32 v194, v194, v195
s_nop 1
v_permlane16_swap_b32 v192, v194
v_add_f32 v192, v192, v194
s_nop 1
v_add_f32_dpp v192, v192, v192 row_ror:8 row_mask:0xf bank_mask:0xf
ds_write_b32 v255, v192
L_g3_go:
s_waitcnt lgkmcnt(0)
s_barrier
s_cmp_lg_u32 s64, 2
s_cbranch_scc1 L_fin
ds_read_b128 v[172:175], v14
ds_read_b128 v[176:179], v14 offset:16
s_waitcnt lgkmcnt(0)
v_pk_add_f32 v[172:173], v[172:173], v[174:175]
v_pk_add_f32 v[176:177], v[176:177], v[178:179]
v_add_f32 v172, v172, v173
v_add_f32 v176, v176, v177
v_cvt_pk_bf16_f32 v172, v172, v176
v_and_b32 v176, 0xffff0000, v172
v_lshlrev_b32 v172, 16, v172
v_mul_f32 v172, v230, v172
v_mul_f32 v176, v231, v176
v_cvt_pk_bf16_f32 v172, v172, v176
v_and_b32 v176, 0xffff0000, v172
v_lshlrev_b32 v172, 16, v172
v_add_f32 v172, v172, v176
v_cvt_pk_bf16_f32 v172, v172, v172
s_mov_b64 exec, 0xffffffff
buffer_store_short v172, v15, s[56:59], s87 offen
s_cmp_lg_u32 s83, 0
s_cbranch_scc1 L_noep
s_mov_b64 exec, 1
v_mov_b32 v168, 0
v_mov_b32 v170, s77
buffer_store_dword v170, v168, s[52:55], 0 offen
L_noep:
s_mov_b64 exec, -1
L_fin:
L_end:
s_endpgm
.section .rodata,"a"
.p2align 6
.amdhsa_kernel gated_mix__sliding_block_cached__sliding_block_cached__decode_kernel
  .amdhsa_next_free_vgpr 256
  .amdhsa_next_free_sgpr 102
  .amdhsa_accum_offset 256
  .amdhsa_group_segment_fixed_size 0
  .amdhsa_kernarg_size 112
  .amdhsa_user_sgpr_count 2
  .amdhsa_user_sgpr_kernarg_segment_ptr 1
  .amdhsa_system_sgpr_workgroup_id_x 1
  .amdhsa_float_denorm_mode_32 3
.end_amdhsa_kernel
```
